```python
import torch

def _softmax(x, axis=-1):
    return torch.softmax(x, dim=axis)
def _gelu(x):
    return torch.nn.functional.gelu(x, approximate="tanh")
def _silu(x):
    return torch.nn.functional.silu(x)
def _sigmoid(x):
    return torch.sigmoid(x)
def _layernorm(x, axis=-1, eps=1e-5):
    m = x.mean(dim=axis, keepdim=True)
    v = x.var(dim=axis, keepdim=True, unbiased=False)
    return (x - m) / torch.sqrt(v + eps)
def _scatter_add(tgt, idx, src, axis=0):
    return tgt.clone().index_add_(axis, idx, src)
def _segment_sum(src, seg, n):
    out = torch.zeros((n,) + src.shape[1:], dtype=src.dtype)
    return out.index_add_(0, seg, src)
def _pad(x, pw):
    flat = tuple(v for pair in reversed(pw) for v in pair)
    return torch.nn.functional.pad(x, flat)

kernel_name = 'standalone__grn__sampling'

def setup_inputs():

    _w = (lambda a: (lambda t: t.to(torch.bfloat16) if t.is_floating_point() else t)(torch.as_tensor(a)))
    B, S, D = 512, 32, 640
    return {
        "x": _w((lambda *s: torch.randn(*s, dtype=torch.bfloat16) * 0.05)(B, S, D)),
        "g": _w((lambda *s: torch.randn(*s, dtype=torch.bfloat16) * 0.8)(D) * 0.1),
        "b": _w((lambda *s: torch.randn(*s, dtype=torch.bfloat16) * 0.1)(D) * 0.1),
    }

def reference(x, g, b):
    gx = torch.sqrt((x * x).sum(axis=-2, keepdims=True))
    nx = gx / (gx.mean(axis=-1, keepdims=True) + 1e-6)
    return g * (x * nx) + b + x
```

```asm
; @launch grid=(512,1,1) block=(320,1,1) lds=64
.amdgcn_target "amdgcn-amd-amdhsa--gfx950"
.text
.globl standalone__grn__sampling_kernel
.p2align 8
.type standalone__grn__sampling_kernel,@function
standalone__grn__sampling_kernel:
    s_load_dwordx2 s[4:5], s[0:1], 0
    s_load_dwordx2 s[8:9], s[0:1], 8
    s_load_dwordx2 s[12:13], s[0:1], 16
    s_load_dwordx2 s[16:17], s[0:1], 24
    s_cmpk_ge_u32 s2, 512
    s_cbranch_scc1 L_end
    s_mov_b32 s6, 20971520
    s_mov_b32 s7, 0x20000
    s_mul_i32 s20, s2, 40960
    v_and_b32 v1, 15, v0
    v_lshlrev_b32 v1, 4, v1
    v_lshrrev_b32 v2, 6, v0
    v_lshl_add_u32 v1, v2, 8, v1
    v_bfe_u32 v3, v0, 4, 2
    v_mul_u32_u24 v4, 1280, v3
    v_add_u32 v4, v4, v1
    s_movk_i32 s10, 1280
    s_mov_b32 s11, s7
    s_mov_b32 s14, s10
    s_mov_b32 s15, s7
    v_lshl_add_u32 v5, v3, 2, v1
    s_mov_b32 s30, 0xffff0000
    s_waitcnt lgkmcnt(0)
    buffer_load_dwordx4 v[44:47], v4, s[4:7], s20 offen nt
    s_add_u32 s21, s20, 5120
    buffer_load_dwordx4 v[52:55], v4, s[4:7], s21 offen nt
    s_add_u32 s22, s20, 10240
    buffer_load_dword v16, v5, s[8:11], 0 offen
    buffer_load_dwordx4 v[12:15], v1, s[12:15], 0 offen
    buffer_load_dwordx4 v[60:63], v4, s[4:7], s22 offen nt
    s_add_u32 s23, s20, 15360
    buffer_load_dwordx4 v[68:71], v4, s[4:7], s23 offen nt
    s_add_u32 s24, s20, 20480
    buffer_load_dwordx4 v[76:79], v4, s[4:7], s24 offen nt
    s_add_u32 s25, s20, 25600
    buffer_load_dwordx4 v[84:87], v4, s[4:7], s25 offen nt
    s_add_u32 s26, s20, 30720
    buffer_load_dwordx4 v[92:95], v4, s[4:7], s26 offen nt
    s_add_u32 s27, s20, 35840
    buffer_load_dwordx4 v[100:103], v4, s[4:7], s27 offen nt
    s_mov_b32 s18, s6
    s_mov_b32 s19, s7
    v_cmp_eq_u32 vcc, 3, v3
    v_lshlrev_b32 v6, 2, v2
    v_mov_b32 v7, 0
    v_cndmask_b32 v6, 32, v6, vcc
    v_mov_b32 v2, 1.0
    v_mov_b32 v3, 1.0
    s_mov_b32 s31, 0x3acccccd
    v_mov_b32 v22, 0x358637bd
    s_waitcnt vmcnt(9)
    v_lshlrev_b32 v40, 16, v44
    v_and_b32 v41, s30, v44
    v_lshlrev_b32 v42, 16, v45
    v_and_b32 v43, s30, v45
    v_lshlrev_b32 v44, 16, v46
    v_and_b32 v45, s30, v46
    v_lshlrev_b32 v46, 16, v47
    v_and_b32 v47, s30, v47
    v_pk_mul_f32 v[24:25], v[40:41], v[40:41]
    v_pk_mul_f32 v[26:27], v[42:43], v[42:43]
    v_pk_mul_f32 v[28:29], v[44:45], v[44:45]
    v_pk_mul_f32 v[30:31], v[46:47], v[46:47]
    s_waitcnt vmcnt(8)
    v_lshlrev_b32 v48, 16, v52
    v_and_b32 v49, s30, v52
    v_lshlrev_b32 v50, 16, v53
    v_and_b32 v51, s30, v53
    v_lshlrev_b32 v52, 16, v54
    v_and_b32 v53, s30, v54
    v_lshlrev_b32 v54, 16, v55
    v_and_b32 v55, s30, v55
    v_pk_fma_f32 v[24:25], v[48:49], v[48:49], v[24:25]
    v_pk_fma_f32 v[26:27], v[50:51], v[50:51], v[26:27]
    v_pk_fma_f32 v[28:29], v[52:53], v[52:53], v[28:29]
    v_pk_fma_f32 v[30:31], v[54:55], v[54:55], v[30:31]
    s_waitcnt vmcnt(5)
    v_lshlrev_b32 v56, 16, v60
    v_and_b32 v57, s30, v60
    v_lshlrev_b32 v58, 16, v61
    v_and_b32 v59, s30, v61
    v_lshlrev_b32 v60, 16, v62
    v_and_b32 v61, s30, v62
    v_lshlrev_b32 v62, 16, v63
    v_and_b32 v63, s30, v63
    v_pk_fma_f32 v[24:25], v[56:57], v[56:57], v[24:25]
    v_pk_fma_f32 v[26:27], v[58:59], v[58:59], v[26:27]
    v_pk_fma_f32 v[28:29], v[60:61], v[60:61], v[28:29]
    v_pk_fma_f32 v[30:31], v[62:63], v[62:63], v[30:31]
    v_lshlrev_b32 v17, 16, v16
    v_and_b32 v18, s30, v16
    v_lshlrev_b32 v8, 16, v12
    v_and_b32 v9, s30, v12
    v_lshlrev_b32 v10, 16, v13
    v_and_b32 v11, s30, v13
    v_lshlrev_b32 v12, 16, v14
    v_and_b32 v13, s30, v14
    v_lshlrev_b32 v14, 16, v15
    v_and_b32 v15, s30, v15
    s_waitcnt vmcnt(4)
    v_lshlrev_b32 v64, 16, v68
    v_and_b32 v65, s30, v68
    v_lshlrev_b32 v66, 16, v69
    v_and_b32 v67, s30, v69
    v_lshlrev_b32 v68, 16, v70
    v_and_b32 v69, s30, v70
    v_lshlrev_b32 v70, 16, v71
    v_and_b32 v71, s30, v71
    v_pk_fma_f32 v[24:25], v[64:65], v[64:65], v[24:25]
    v_pk_fma_f32 v[26:27], v[66:67], v[66:67], v[26:27]
    v_pk_fma_f32 v[28:29], v[68:69], v[68:69], v[28:29]
    v_pk_fma_f32 v[30:31], v[70:71], v[70:71], v[30:31]
    s_waitcnt vmcnt(3)
    v_lshlrev_b32 v72, 16, v76
    v_and_b32 v73, s30, v76
    v_lshlrev_b32 v74, 16, v77
    v_and_b32 v75, s30, v77
    v_lshlrev_b32 v76, 16, v78
    v_and_b32 v77, s30, v78
    v_lshlrev_b32 v78, 16, v79
    v_and_b32 v79, s30, v79
    v_pk_fma_f32 v[24:25], v[72:73], v[72:73], v[24:25]
    v_pk_fma_f32 v[26:27], v[74:75], v[74:75], v[26:27]
    v_pk_fma_f32 v[28:29], v[76:77], v[76:77], v[28:29]
    v_pk_fma_f32 v[30:31], v[78:79], v[78:79], v[30:31]
    s_waitcnt vmcnt(2)
    v_lshlrev_b32 v80, 16, v84
    v_and_b32 v81, s30, v84
    v_lshlrev_b32 v82, 16, v85
    v_and_b32 v83, s30, v85
    v_lshlrev_b32 v84, 16, v86
    v_and_b32 v85, s30, v86
    v_lshlrev_b32 v86, 16, v87
    v_and_b32 v87, s30, v87
    v_pk_fma_f32 v[24:25], v[80:81], v[80:81], v[24:25]
    v_pk_fma_f32 v[26:27], v[82:83], v[82:83], v[26:27]
    v_pk_fma_f32 v[28:29], v[84:85], v[84:85], v[28:29]
    v_pk_fma_f32 v[30:31], v[86:87], v[86:87], v[30:31]
    s_waitcnt vmcnt(1)
    v_lshlrev_b32 v88, 16, v92
    v_and_b32 v89, s30, v92
    v_lshlrev_b32 v90, 16, v93
    v_and_b32 v91, s30, v93
    v_lshlrev_b32 v92, 16, v94
    v_and_b32 v93, s30, v94
    v_lshlrev_b32 v94, 16, v95
    v_and_b32 v95, s30, v95
    v_pk_fma_f32 v[24:25], v[88:89], v[88:89], v[24:25]
    v_pk_fma_f32 v[26:27], v[90:91], v[90:91], v[26:27]
    v_pk_fma_f32 v[28:29], v[92:93], v[92:93], v[28:29]
    v_pk_fma_f32 v[30:31], v[94:95], v[94:95], v[30:31]
    s_waitcnt vmcnt(0)
    v_lshlrev_b32 v96, 16, v100
    v_and_b32 v97, s30, v100
    v_lshlrev_b32 v98, 16, v101
    v_and_b32 v99, s30, v101
    v_lshlrev_b32 v100, 16, v102
    v_and_b32 v101, s30, v102
    v_lshlrev_b32 v102, 16, v103
    v_and_b32 v103, s30, v103
    v_pk_fma_f32 v[24:25], v[96:97], v[96:97], v[24:25]
    v_pk_fma_f32 v[26:27], v[98:99], v[98:99], v[26:27]
    v_pk_fma_f32 v[28:29], v[100:101], v[100:101], v[28:29]
    v_pk_fma_f32 v[30:31], v[102:103], v[102:103], v[30:31]
    s_nop 1
    v_permlane32_swap_b32 v24, v28
    v_permlane32_swap_b32 v25, v29
    v_permlane32_swap_b32 v26, v30
    v_permlane32_swap_b32 v27, v31
    v_pk_add_f32 v[24:25], v[24:25], v[28:29]
    v_pk_add_f32 v[26:27], v[26:27], v[30:31]
    s_nop 1
    v_permlane16_swap_b32 v24, v26
    v_permlane16_swap_b32 v25, v27
    v_pk_add_f32 v[24:25], v[24:25], v[26:27]
    v_sqrt_f32 v24, v24
    v_sqrt_f32 v25, v25
    s_nop 0
    v_add_f32 v20, v24, v25
    v_mul_f32 v32, v17, v24
    v_mul_f32 v33, v18, v25
    v_add_f32_dpp v20, v20, v20 quad_perm:[1,0,3,2] row_mask:0xf bank_mask:0xf
    v_mov_b32 v34, v32
    v_mov_b32 v35, v33
    v_add_f32_dpp v20, v20, v20 quad_perm:[2,3,0,1] row_mask:0xf bank_mask:0xf
    s_nop 1
    v_add_f32_dpp v20, v20, v20 row_half_mirror row_mask:0xf bank_mask:0xf
    v_permlane16_swap_b32 v32, v34
    v_permlane16_swap_b32 v33, v35
    v_add_f32_dpp v20, v20, v20 row_mirror row_mask:0xf bank_mask:0xf
    v_mov_b32 v36, v32
    v_mov_b32 v37, v33
    v_add_f32_dpp v20, v20, v20 row_bcast:15 row_mask:0xa bank_mask:0xf
    v_mov_b32 v38, v34
    v_mov_b32 v39, v35
    v_add_f32_dpp v20, v20, v20 row_bcast:31 row_mask:0xc bank_mask:0xf
    ds_write_b32 v6, v20
    v_permlane32_swap_b32 v32, v36
    v_permlane32_swap_b32 v33, v37
    v_permlane32_swap_b32 v34, v38
    v_permlane32_swap_b32 v35, v39
    s_waitcnt lgkmcnt(0)
    s_barrier
    ds_read_b128 v[28:31], v7
    ds_read_b32 v19, v7 offset:16
    s_waitcnt lgkmcnt(0)
    v_pk_add_f32 v[28:29], v[28:29], v[30:31]
    v_add_f32 v20, v28, v19
    v_add_f32 v20, v20, v29
    v_fma_f32 v20, v20, s31, v22
    v_rcp_f32 v20, v20
    s_nop 0
    v_pk_fma_f32 v[32:33], v[32:33], v[20:21], v[2:3] op_sel_hi:[1,0,1]
    v_pk_fma_f32 v[34:35], v[34:35], v[20:21], v[2:3] op_sel_hi:[1,0,1]
    v_pk_fma_f32 v[36:37], v[36:37], v[20:21], v[2:3] op_sel_hi:[1,0,1]
    v_pk_fma_f32 v[38:39], v[38:39], v[20:21], v[2:3] op_sel_hi:[1,0,1]
    v_pk_fma_f32 v[40:41], v[40:41], v[32:33], v[8:9]
    v_pk_fma_f32 v[42:43], v[42:43], v[34:35], v[10:11]
    v_pk_fma_f32 v[44:45], v[44:45], v[36:37], v[12:13]
    v_pk_fma_f32 v[46:47], v[46:47], v[38:39], v[14:15]
    v_cvt_pk_bf16_f32 v40, v40, v41
    v_cvt_pk_bf16_f32 v41, v42, v43
    v_cvt_pk_bf16_f32 v42, v44, v45
    v_cvt_pk_bf16_f32 v43, v46, v47
    buffer_store_dwordx4 v[40:43], v4, s[16:19], s20 offen nt
    v_pk_fma_f32 v[48:49], v[48:49], v[32:33], v[8:9]
    v_pk_fma_f32 v[50:51], v[50:51], v[34:35], v[10:11]
    v_pk_fma_f32 v[52:53], v[52:53], v[36:37], v[12:13]
    v_pk_fma_f32 v[54:55], v[54:55], v[38:39], v[14:15]
    v_cvt_pk_bf16_f32 v48, v48, v49
    v_cvt_pk_bf16_f32 v49, v50, v51
    v_cvt_pk_bf16_f32 v50, v52, v53
    v_cvt_pk_bf16_f32 v51, v54, v55
    buffer_store_dwordx4 v[48:51], v4, s[16:19], s21 offen nt
    v_pk_fma_f32 v[56:57], v[56:57], v[32:33], v[8:9]
    v_pk_fma_f32 v[58:59], v[58:59], v[34:35], v[10:11]
    v_pk_fma_f32 v[60:61], v[60:61], v[36:37], v[12:13]
    v_pk_fma_f32 v[62:63], v[62:63], v[38:39], v[14:15]
    v_cvt_pk_bf16_f32 v56, v56, v57
    v_cvt_pk_bf16_f32 v57, v58, v59
    v_cvt_pk_bf16_f32 v58, v60, v61
    v_cvt_pk_bf16_f32 v59, v62, v63
    buffer_store_dwordx4 v[56:59], v4, s[16:19], s22 offen nt
    v_pk_fma_f32 v[64:65], v[64:65], v[32:33], v[8:9]
    v_pk_fma_f32 v[66:67], v[66:67], v[34:35], v[10:11]
    v_pk_fma_f32 v[68:69], v[68:69], v[36:37], v[12:13]
    v_pk_fma_f32 v[70:71], v[70:71], v[38:39], v[14:15]
    v_cvt_pk_bf16_f32 v64, v64, v65
    v_cvt_pk_bf16_f32 v65, v66, v67
    v_cvt_pk_bf16_f32 v66, v68, v69
    v_cvt_pk_bf16_f32 v67, v70, v71
    buffer_store_dwordx4 v[64:67], v4, s[16:19], s23 offen nt
    v_pk_fma_f32 v[72:73], v[72:73], v[32:33], v[8:9]
    v_pk_fma_f32 v[74:75], v[74:75], v[34:35], v[10:11]
    v_pk_fma_f32 v[76:77], v[76:77], v[36:37], v[12:13]
    v_pk_fma_f32 v[78:79], v[78:79], v[38:39], v[14:15]
    v_cvt_pk_bf16_f32 v72, v72, v73
    v_cvt_pk_bf16_f32 v73, v74, v75
    v_cvt_pk_bf16_f32 v74, v76, v77
    v_cvt_pk_bf16_f32 v75, v78, v79
    buffer_store_dwordx4 v[72:75], v4, s[16:19], s24 offen nt
    v_pk_fma_f32 v[80:81], v[80:81], v[32:33], v[8:9]
    v_pk_fma_f32 v[82:83], v[82:83], v[34:35], v[10:11]
    v_pk_fma_f32 v[84:85], v[84:85], v[36:37], v[12:13]
    v_pk_fma_f32 v[86:87], v[86:87], v[38:39], v[14:15]
    v_cvt_pk_bf16_f32 v80, v80, v81
    v_cvt_pk_bf16_f32 v81, v82, v83
    v_cvt_pk_bf16_f32 v82, v84, v85
    v_cvt_pk_bf16_f32 v83, v86, v87
    buffer_store_dwordx4 v[80:83], v4, s[16:19], s25 offen nt
    v_pk_fma_f32 v[88:89], v[88:89], v[32:33], v[8:9]
    v_pk_fma_f32 v[90:91], v[90:91], v[34:35], v[10:11]
    v_pk_fma_f32 v[92:93], v[92:93], v[36:37], v[12:13]
    v_pk_fma_f32 v[94:95], v[94:95], v[38:39], v[14:15]
    v_cvt_pk_bf16_f32 v88, v88, v89
    v_cvt_pk_bf16_f32 v89, v90, v91
    v_cvt_pk_bf16_f32 v90, v92, v93
    v_cvt_pk_bf16_f32 v91, v94, v95
    buffer_store_dwordx4 v[88:91], v4, s[16:19], s26 offen nt
    v_pk_fma_f32 v[96:97], v[96:97], v[32:33], v[8:9]
    v_pk_fma_f32 v[98:99], v[98:99], v[34:35], v[10:11]
    v_pk_fma_f32 v[100:101], v[100:101], v[36:37], v[12:13]
    v_pk_fma_f32 v[102:103], v[102:103], v[38:39], v[14:15]
    v_cvt_pk_bf16_f32 v96, v96, v97
    v_cvt_pk_bf16_f32 v97, v98, v99
    v_cvt_pk_bf16_f32 v98, v100, v101
    v_cvt_pk_bf16_f32 v99, v102, v103
    buffer_store_dwordx4 v[96:99], v4, s[16:19], s27 offen
L_end:
    s_endpgm
.section .rodata,"a"
.p2align 6
.amdhsa_kernel standalone__grn__sampling_kernel
  .amdhsa_next_free_vgpr 104
  .amdhsa_next_free_sgpr 32
  .amdhsa_accum_offset 104
  .amdhsa_group_segment_fixed_size 0
  .amdhsa_kernarg_size 48
  .amdhsa_user_sgpr_count 2
  .amdhsa_user_sgpr_kernarg_segment_ptr 1
  .amdhsa_system_sgpr_workgroup_id_x 1
  .amdhsa_float_denorm_mode_32 3
.end_amdhsa_kernel
```
